```python
import torch

def _softmax(x, axis=-1):
    return torch.softmax(x, dim=axis)
def _gelu(x):
    return torch.nn.functional.gelu(x, approximate="tanh")
def _silu(x):
    return torch.nn.functional.silu(x)
def _sigmoid(x):
    return torch.sigmoid(x)
def _layernorm(x, axis=-1, eps=1e-5):
    m = x.mean(dim=axis, keepdim=True)
    v = x.var(dim=axis, keepdim=True, unbiased=False)
    return (x - m) / torch.sqrt(v + eps)
def _scatter_add(tgt, idx, src, axis=0):
    return tgt.clone().index_add_(axis, idx, src)
def _segment_sum(src, seg, n):
    out = torch.zeros((n,) + src.shape[1:], dtype=src.dtype)
    return out.index_add_(0, seg, src)
def _pad(x, pw):
    flat = tuple(v for pair in reversed(pw) for v in pair)
    return torch.nn.functional.pad(x, flat)

kernel_name = 'standalone__channel_attn_cbam__vision'

def setup_inputs():

    _w = (lambda a: (lambda t: t.to(torch.bfloat16) if t.is_floating_point() else t)(torch.as_tensor(a)))
    H = W = 224
    C = 192
    r = max(C // 4, 1)
    return {
        "x": _w((lambda *s: torch.randn(*s, dtype=torch.bfloat16) * 0.2)(1, H, W, C) + (lambda *s: torch.randn(*s, dtype=torch.bfloat16) * 0.2)(1, 1, 1, C) * 2.0),
        "w1": _w((lambda *s: torch.randn(*s, dtype=torch.bfloat16) * 0.2)(C, r)),
        "w2": _w((lambda *s: torch.randn(*s, dtype=torch.bfloat16) * 0.2)(r, C)),
    }

def reference(x, w1, w2):
    B, H, W, C = x.shape
    xf = x.reshape(B, H * W, C)
    gap = torch.mean(xf, 1)
    gmp = torch.amax(xf, 1)
    h_a = gap @ w1
    h_a = h_a * (lambda x, dt: x.to(dt))(h_a > 0, h_a.dtype)
    h_m = gmp @ w1
    h_m = h_m * (lambda x, dt: x.to(dt))(h_m > 0, h_m.dtype)
    scale = _sigmoid(h_a @ w2 + h_m @ w2)
    return x * scale[:, None, None, :]
```

```asm
; @launch grid=(256,1,1) block=(192,1,1) lds=19200
.amdgcn_target "amdgcn-amd-amdhsa--gfx950"
.text
.globl standalone__channel_attn_cbam__vision_kernel
.p2align 8
.type standalone__channel_attn_cbam__vision_kernel,@function
standalone__channel_attn_cbam__vision_kernel:
s_load_dwordx8 s[4:11], s[0:1], 0
s_load_dwordx4 s[12:15], s[0:1], 32
s_cmp_ge_u32 s2, 256
s_cbranch_scc1 L_end
s_cmp_ge_u32 s2, 8
s_cbranch_scc1 L_nopf
s_getpc_b64 s[30:31]
v_mul_u32_u24 v4, 40, v0
global_load_dword v5, v4, s[30:31]
L_nopf:
v_lshrrev_b32 v3, 6, v0
v_and_b32 v2, 63, v0
v_readfirstlane_b32 s3, v3
s_cmp_lt_u32 s2, 32
s_cbranch_scc1 L_red
s_sub_u32 s2, s2, 32
s_and_b32 s29, s2, 7
s_mul_i32 s29, s29, 28
s_lshr_b32 s16, s2, 3
s_add_u32 s29, s29, s16
s_mul_i32 s16, s29, 12288
v_lshrrev_b32 v4, 3, v2
v_and_b32 v6, 7, v2
v_mul_u32_u24 v4, 384, v4
v_lshl_add_u32 v4, v3, 7, v4
v_lshl_add_u32 v4, v6, 4, v4
s_add_u32 s16, s16, 3072
s_mov_b32 s32, 6144
s_mov_b32 s33, 2746368
v_add_u32 v1, s16, v4
v_mov_b32 v4, v1
v_mov_b32 v7, 851968
s_waitcnt lgkmcnt(0)
global_load_dwordx4 v[16:19], v4, s[4:5] offset:-3072 nt
global_load_dwordx4 v[20:23], v4, s[4:5] offset:0 nt
global_load_dwordx4 v[24:27], v4, s[4:5] offset:3072 nt
v_add_u32 v4, s32, v4
global_load_dwordx4 v[28:31], v4, s[4:5] offset:0 nt
v_add_u32 v4, s33, v4
global_load_dwordx4 v[32:35], v4, s[4:5] offset:-3072 nt
global_load_dwordx4 v[36:39], v4, s[4:5] offset:0 nt
global_load_dword v8, v7, s[14:15]
global_load_dwordx4 v[40:43], v4, s[4:5] offset:3072 nt
v_add_u32 v4, s32, v4
global_load_dwordx4 v[44:47], v4, s[4:5] offset:0 nt
v_add_u32 v4, s33, v4
global_load_dwordx4 v[48:51], v4, s[4:5] offset:-3072 nt
global_load_dwordx4 v[52:55], v4, s[4:5] offset:0 nt
global_load_dwordx4 v[56:59], v4, s[4:5] offset:3072 nt
v_add_u32 v4, s32, v4
global_load_dwordx4 v[60:63], v4, s[4:5] offset:0 nt
v_add_u32 v4, s33, v4
global_load_dwordx4 v[64:67], v4, s[4:5] offset:-3072 nt
global_load_dwordx4 v[68:71], v4, s[4:5] offset:0 nt
global_load_dwordx4 v[72:75], v4, s[4:5] offset:3072 nt
v_add_u32 v4, s32, v4
global_load_dwordx4 v[76:79], v4, s[4:5] offset:0 nt
v_add_u32 v4, s33, v4
global_load_dwordx4 v[80:83], v4, s[4:5] offset:-3072 nt
global_load_dwordx4 v[84:87], v4, s[4:5] offset:0 nt
global_load_dwordx4 v[88:91], v4, s[4:5] offset:3072 nt
v_add_u32 v4, s32, v4
global_load_dwordx4 v[92:95], v4, s[4:5] offset:0 nt
v_add_u32 v4, s33, v4
global_load_dwordx4 v[96:99], v4, s[4:5] offset:-3072 nt
global_load_dwordx4 v[100:103], v4, s[4:5] offset:0 nt
global_load_dwordx4 v[104:107], v4, s[4:5] offset:3072 nt
v_add_u32 v4, s32, v4
global_load_dwordx4 v[108:111], v4, s[4:5] offset:0 nt
v_add_u32 v4, s33, v4
global_load_dwordx4 v[112:115], v4, s[4:5] offset:-3072 nt
global_load_dwordx4 v[116:119], v4, s[4:5] offset:0 nt
global_load_dwordx4 v[120:123], v4, s[4:5] offset:3072 nt
v_add_u32 v4, s32, v4
global_load_dwordx4 v[124:127], v4, s[4:5] offset:0 nt
v_and_b32 v9, 1, v2
v_lshlrev_b32 v9, 4, v9
s_movk_i32 s18, 0x3f80
v_lshlrev_b32 v9, v9, s18
v_mov_b32 v224, 0
v_mov_b32 v225, 0
v_mov_b32 v226, 0
v_mov_b32 v227, 0
v_mov_b32_dpp v224, v9 quad_perm:[0,1,2,3] row_mask:0xf bank_mask:0x1
v_mov_b32_dpp v225, v9 quad_perm:[0,1,2,3] row_mask:0xf bank_mask:0x2
v_mov_b32_dpp v226, v9 quad_perm:[0,1,2,3] row_mask:0xf bank_mask:0x4
v_mov_b32_dpp v227, v9 quad_perm:[0,1,2,3] row_mask:0xf bank_mask:0x8
s_mov_b32 s19, 0xffff0000
v_lshrrev_b32 v9, 4, v2
v_and_b32 v10, 4, v2
v_add_u32 v9, v9, v10
v_lshl_add_u32 v9, v3, 3, v9
v_and_b32 v10, 3, v2
v_lshl_add_u32 v9, v9, 2, v10
s_and_b32 s27, s2, 7
s_lshr_b32 s20, s2, 3
s_mul_i32 s20, s20, 1664
s_mul_i32 s28, s27, 49152
s_add_u32 s20, s20, s28
v_lshl_add_u32 v9, v9, 4, s20
s_mov_b32 s22, 0x07060302
s_waitcnt vmcnt(27)
v_mfma_f32_16x16x32_bf16 v[252:255], v[224:227], v[16:19], 0
v_pk_maximum3_f16 v236, v16, v16, v20
v_pk_maximum3_f16 v237, v17, v17, v21
v_mfma_f32_16x16x32_bf16 v[248:251], v[224:227], v[20:23], 0
v_pk_maximum3_f16 v238, v18, v18, v22
v_pk_maximum3_f16 v239, v19, v19, v23
s_waitcnt vmcnt(25)
v_mfma_f32_16x16x32_bf16 v[252:255], v[224:227], v[24:27], v[252:255]
v_pk_maximum3_f16 v236, v236, v24, v28
v_pk_maximum3_f16 v237, v237, v25, v29
v_mfma_f32_16x16x32_bf16 v[248:251], v[224:227], v[28:31], v[248:251]
v_pk_maximum3_f16 v238, v238, v26, v30
v_pk_maximum3_f16 v239, v239, v27, v31
s_waitcnt vmcnt(23)
v_mfma_f32_16x16x32_bf16 v[252:255], v[224:227], v[32:35], v[252:255]
v_pk_maximum3_f16 v236, v236, v32, v36
v_pk_maximum3_f16 v237, v237, v33, v37
v_mfma_f32_16x16x32_bf16 v[248:251], v[224:227], v[36:39], v[248:251]
v_pk_maximum3_f16 v238, v238, v34, v38
v_pk_maximum3_f16 v239, v239, v35, v39
s_waitcnt vmcnt(20)
v_mfma_f32_16x16x32_bf16 v[252:255], v[224:227], v[40:43], v[252:255]
v_pk_maximum3_f16 v236, v236, v40, v44
v_pk_maximum3_f16 v237, v237, v41, v45
v_mfma_f32_16x16x32_bf16 v[248:251], v[224:227], v[44:47], v[248:251]
v_pk_maximum3_f16 v238, v238, v42, v46
v_pk_maximum3_f16 v239, v239, v43, v47
s_waitcnt vmcnt(18)
v_mfma_f32_16x16x32_bf16 v[252:255], v[224:227], v[48:51], v[252:255]
v_pk_maximum3_f16 v236, v236, v48, v52
v_pk_maximum3_f16 v237, v237, v49, v53
v_mfma_f32_16x16x32_bf16 v[248:251], v[224:227], v[52:55], v[248:251]
v_pk_maximum3_f16 v238, v238, v50, v54
v_pk_maximum3_f16 v239, v239, v51, v55
s_waitcnt vmcnt(16)
v_mfma_f32_16x16x32_bf16 v[252:255], v[224:227], v[56:59], v[252:255]
v_pk_maximum3_f16 v236, v236, v56, v60
v_pk_maximum3_f16 v237, v237, v57, v61
v_mfma_f32_16x16x32_bf16 v[248:251], v[224:227], v[60:63], v[248:251]
v_pk_maximum3_f16 v238, v238, v58, v62
v_pk_maximum3_f16 v239, v239, v59, v63
s_waitcnt vmcnt(14)
v_mfma_f32_16x16x32_bf16 v[252:255], v[224:227], v[64:67], v[252:255]
v_pk_maximum3_f16 v236, v236, v64, v68
v_pk_maximum3_f16 v237, v237, v65, v69
v_mfma_f32_16x16x32_bf16 v[248:251], v[224:227], v[68:71], v[248:251]
v_pk_maximum3_f16 v238, v238, v66, v70
v_pk_maximum3_f16 v239, v239, v67, v71
s_waitcnt vmcnt(12)
v_mfma_f32_16x16x32_bf16 v[252:255], v[224:227], v[72:75], v[252:255]
v_pk_maximum3_f16 v236, v236, v72, v76
v_pk_maximum3_f16 v237, v237, v73, v77
v_mfma_f32_16x16x32_bf16 v[248:251], v[224:227], v[76:79], v[248:251]
v_pk_maximum3_f16 v238, v238, v74, v78
v_pk_maximum3_f16 v239, v239, v75, v79
s_waitcnt vmcnt(10)
v_mfma_f32_16x16x32_bf16 v[252:255], v[224:227], v[80:83], v[252:255]
v_pk_maximum3_f16 v236, v236, v80, v84
v_pk_maximum3_f16 v237, v237, v81, v85
v_mfma_f32_16x16x32_bf16 v[248:251], v[224:227], v[84:87], v[248:251]
v_pk_maximum3_f16 v238, v238, v82, v86
v_pk_maximum3_f16 v239, v239, v83, v87
s_waitcnt vmcnt(8)
v_mfma_f32_16x16x32_bf16 v[252:255], v[224:227], v[88:91], v[252:255]
v_pk_maximum3_f16 v236, v236, v88, v92
v_pk_maximum3_f16 v237, v237, v89, v93
v_mfma_f32_16x16x32_bf16 v[248:251], v[224:227], v[92:95], v[248:251]
v_pk_maximum3_f16 v238, v238, v90, v94
v_pk_maximum3_f16 v239, v239, v91, v95
s_waitcnt vmcnt(6)
v_mfma_f32_16x16x32_bf16 v[252:255], v[224:227], v[96:99], v[252:255]
v_pk_maximum3_f16 v236, v236, v96, v100
v_pk_maximum3_f16 v237, v237, v97, v101
v_mfma_f32_16x16x32_bf16 v[248:251], v[224:227], v[100:103], v[248:251]
v_pk_maximum3_f16 v238, v238, v98, v102
v_pk_maximum3_f16 v239, v239, v99, v103
s_waitcnt vmcnt(4)
v_mfma_f32_16x16x32_bf16 v[252:255], v[224:227], v[104:107], v[252:255]
v_pk_maximum3_f16 v236, v236, v104, v108
v_pk_maximum3_f16 v237, v237, v105, v109
v_mfma_f32_16x16x32_bf16 v[248:251], v[224:227], v[108:111], v[248:251]
v_pk_maximum3_f16 v238, v238, v106, v110
v_pk_maximum3_f16 v239, v239, v107, v111
s_waitcnt vmcnt(2)
v_add_u32 v8, 0x9e3779b1, v8
v_mfma_f32_16x16x32_bf16 v[252:255], v[224:227], v[112:115], v[252:255]
v_pk_maximum3_f16 v236, v236, v112, v116
v_pk_maximum3_f16 v237, v237, v113, v117
v_mfma_f32_16x16x32_bf16 v[248:251], v[224:227], v[116:119], v[248:251]
v_pk_maximum3_f16 v238, v238, v114, v118
v_pk_maximum3_f16 v239, v239, v115, v119
s_waitcnt vmcnt(0)
v_mfma_f32_16x16x32_bf16 v[252:255], v[224:227], v[120:123], v[252:255]
v_pk_maximum3_f16 v236, v236, v120, v124
v_pk_maximum3_f16 v237, v237, v121, v125
v_mfma_f32_16x16x32_bf16 v[248:251], v[224:227], v[124:127], v[248:251]
v_pk_maximum3_f16 v238, v238, v122, v126
v_pk_maximum3_f16 v239, v239, v123, v127
s_movk_i32 s23, 3
v_permlane32_swap_b32 v236, v238
v_permlane32_swap_b32 v237, v239
v_pk_maximum3_f16 v236, v236, v238, v238
v_pk_maximum3_f16 v237, v237, v239, v239
v_mov_b32 v255, v8
v_pk_add_f32 v[252:253], v[252:253], v[248:249]
v_permlane16_swap_b32 v236, v237
v_pk_maximum3_f16 v236, v236, v237, v237
v_add_f32_dpp v252, v252, v252 row_ror:8 row_mask:0xf bank_mask:0xf
v_add_f32_dpp v253, v253, v253 row_ror:8 row_mask:0xf bank_mask:0xf
v_mov_b32_dpp v237, v236 row_ror:8 row_mask:0xf bank_mask:0xf
v_cmp_u_f16_sdwa vcc, v236, v236 src0_sel:WORD_0 src1_sel:WORD_1
v_pk_maximum3_f16 v254, v236, v237, v237
s_cbranch_vccnz L_exact
L_exactdone:
s_mov_b32 exec_lo, 0x00ff00ff
s_mov_b32 exec_hi, 0x00ff00ff
global_store_dwordx4 v9, v[252:255], s[14:15]
s_mov_b64 exec, -1
s_lshl_b32 s27, s27, 12
s_add_u32 s27, s27, 655360
v_lshl_add_u32 v12, v0, 2, s27
v_and_b32 v11, 0xffff, v8
s_mov_b32 s21, 1048576
v_lshlrev_b32 v232, 16, v16
v_and_b32 v233, s19, v16
v_lshlrev_b32 v234, 16, v17
v_and_b32 v235, s19, v17
v_lshlrev_b32 v236, 16, v18
v_and_b32 v237, s19, v18
v_lshlrev_b32 v238, 16, v19
v_and_b32 v239, s19, v19
L_poll3:
global_load_dword v10, v12, s[14:15] sc1
s_cmp_eq_u32 s21, 1048476
s_cbranch_scc1 L_fb
L_fbdone:
s_sub_u32 s21, s21, 1
s_cbranch_scc1 L_poll3done
s_waitcnt vmcnt(0)
v_cmp_ne_u16 vcc, v10, v11
s_cbranch_vccnz L_poll3
L_poll3done:
v_xor_b32 v224, v10, v11
v_xor_b32 v228, v10, v11
v_xor_b32_dpp v224, v10, v11 row_ror:8 row_mask:0xf bank_mask:0xc
v_xor_b32_dpp v228, v10, v11 row_ror:8 row_mask:0xf bank_mask:0x3
v_mov_b32 v225, v224
v_mov_b32 v229, v228
s_nop 0
v_permlane16_swap_b32 v224, v225
v_permlane16_swap_b32 v228, v229
v_mov_b64 v[226:227], v[224:225]
v_mov_b64 v[230:231], v[228:229]
s_nop 0
v_permlane32_swap_b32 v224, v226
v_permlane32_swap_b32 v225, v227
v_permlane32_swap_b32 v228, v230
v_permlane32_swap_b32 v229, v231
v_pk_mul_f32 v[232:233], v[232:233], v[224:225]
v_pk_mul_f32 v[234:235], v[234:235], v[226:227]
v_pk_mul_f32 v[236:237], v[236:237], v[228:229]
v_pk_mul_f32 v[238:239], v[238:239], v[230:231]
v_cvt_pk_bf16_f32 v16, v232, v233
v_cvt_pk_bf16_f32 v17, v234, v235
v_cvt_pk_bf16_f32 v18, v236, v237
v_cvt_pk_bf16_f32 v19, v238, v239
global_store_dwordx4 v1, v[16:19], s[10:11] offset:-3072 sc1
v_lshlrev_b32 v232, 16, v20
v_and_b32 v233, s19, v20
v_lshlrev_b32 v234, 16, v21
v_and_b32 v235, s19, v21
v_lshlrev_b32 v236, 16, v22
v_and_b32 v237, s19, v22
v_lshlrev_b32 v238, 16, v23
v_and_b32 v239, s19, v23
v_pk_mul_f32 v[232:233], v[232:233], v[224:225]
v_pk_mul_f32 v[234:235], v[234:235], v[226:227]
v_pk_mul_f32 v[236:237], v[236:237], v[228:229]
v_pk_mul_f32 v[238:239], v[238:239], v[230:231]
v_cvt_pk_bf16_f32 v20, v232, v233
v_cvt_pk_bf16_f32 v21, v234, v235
v_cvt_pk_bf16_f32 v22, v236, v237
v_cvt_pk_bf16_f32 v23, v238, v239
global_store_dwordx4 v1, v[20:23], s[10:11] offset:0 sc1
v_lshlrev_b32 v232, 16, v24
v_and_b32 v233, s19, v24
v_lshlrev_b32 v234, 16, v25
v_and_b32 v235, s19, v25
v_lshlrev_b32 v236, 16, v26
v_and_b32 v237, s19, v26
v_lshlrev_b32 v238, 16, v27
v_and_b32 v239, s19, v27
v_pk_mul_f32 v[232:233], v[232:233], v[224:225]
v_pk_mul_f32 v[234:235], v[234:235], v[226:227]
v_pk_mul_f32 v[236:237], v[236:237], v[228:229]
v_pk_mul_f32 v[238:239], v[238:239], v[230:231]
v_cvt_pk_bf16_f32 v24, v232, v233
v_cvt_pk_bf16_f32 v25, v234, v235
v_cvt_pk_bf16_f32 v26, v236, v237
v_cvt_pk_bf16_f32 v27, v238, v239
global_store_dwordx4 v1, v[24:27], s[10:11] offset:3072 sc1
v_lshlrev_b32 v232, 16, v28
v_and_b32 v233, s19, v28
v_lshlrev_b32 v234, 16, v29
v_and_b32 v235, s19, v29
v_lshlrev_b32 v236, 16, v30
v_and_b32 v237, s19, v30
v_lshlrev_b32 v238, 16, v31
v_and_b32 v239, s19, v31
v_pk_mul_f32 v[232:233], v[232:233], v[224:225]
v_pk_mul_f32 v[234:235], v[234:235], v[226:227]
v_pk_mul_f32 v[236:237], v[236:237], v[228:229]
v_pk_mul_f32 v[238:239], v[238:239], v[230:231]
v_cvt_pk_bf16_f32 v28, v232, v233
v_cvt_pk_bf16_f32 v29, v234, v235
v_cvt_pk_bf16_f32 v30, v236, v237
v_cvt_pk_bf16_f32 v31, v238, v239
v_add_u32 v1, s32, v1
global_store_dwordx4 v1, v[28:31], s[10:11] offset:0 sc1
v_lshlrev_b32 v232, 16, v32
v_and_b32 v233, s19, v32
v_lshlrev_b32 v234, 16, v33
v_and_b32 v235, s19, v33
v_lshlrev_b32 v236, 16, v34
v_and_b32 v237, s19, v34
v_lshlrev_b32 v238, 16, v35
v_and_b32 v239, s19, v35
v_pk_mul_f32 v[232:233], v[232:233], v[224:225]
v_pk_mul_f32 v[234:235], v[234:235], v[226:227]
v_pk_mul_f32 v[236:237], v[236:237], v[228:229]
v_pk_mul_f32 v[238:239], v[238:239], v[230:231]
v_cvt_pk_bf16_f32 v32, v232, v233
v_cvt_pk_bf16_f32 v33, v234, v235
v_cvt_pk_bf16_f32 v34, v236, v237
v_cvt_pk_bf16_f32 v35, v238, v239
v_add_u32 v1, s33, v1
global_store_dwordx4 v1, v[32:35], s[10:11] offset:-3072 sc1
v_lshlrev_b32 v232, 16, v36
v_and_b32 v233, s19, v36
v_lshlrev_b32 v234, 16, v37
v_and_b32 v235, s19, v37
v_lshlrev_b32 v236, 16, v38
v_and_b32 v237, s19, v38
v_lshlrev_b32 v238, 16, v39
v_and_b32 v239, s19, v39
v_pk_mul_f32 v[232:233], v[232:233], v[224:225]
v_pk_mul_f32 v[234:235], v[234:235], v[226:227]
v_pk_mul_f32 v[236:237], v[236:237], v[228:229]
v_pk_mul_f32 v[238:239], v[238:239], v[230:231]
v_cvt_pk_bf16_f32 v36, v232, v233
v_cvt_pk_bf16_f32 v37, v234, v235
v_cvt_pk_bf16_f32 v38, v236, v237
v_cvt_pk_bf16_f32 v39, v238, v239
global_store_dwordx4 v1, v[36:39], s[10:11] offset:0 sc1
v_lshlrev_b32 v232, 16, v40
v_and_b32 v233, s19, v40
v_lshlrev_b32 v234, 16, v41
v_and_b32 v235, s19, v41
v_lshlrev_b32 v236, 16, v42
v_and_b32 v237, s19, v42
v_lshlrev_b32 v238, 16, v43
v_and_b32 v239, s19, v43
v_pk_mul_f32 v[232:233], v[232:233], v[224:225]
v_pk_mul_f32 v[234:235], v[234:235], v[226:227]
v_pk_mul_f32 v[236:237], v[236:237], v[228:229]
v_pk_mul_f32 v[238:239], v[238:239], v[230:231]
v_cvt_pk_bf16_f32 v40, v232, v233
v_cvt_pk_bf16_f32 v41, v234, v235
v_cvt_pk_bf16_f32 v42, v236, v237
v_cvt_pk_bf16_f32 v43, v238, v239
global_store_dwordx4 v1, v[40:43], s[10:11] offset:3072 sc1
v_lshlrev_b32 v232, 16, v44
v_and_b32 v233, s19, v44
v_lshlrev_b32 v234, 16, v45
v_and_b32 v235, s19, v45
v_lshlrev_b32 v236, 16, v46
v_and_b32 v237, s19, v46
v_lshlrev_b32 v238, 16, v47
v_and_b32 v239, s19, v47
v_pk_mul_f32 v[232:233], v[232:233], v[224:225]
v_pk_mul_f32 v[234:235], v[234:235], v[226:227]
v_pk_mul_f32 v[236:237], v[236:237], v[228:229]
v_pk_mul_f32 v[238:239], v[238:239], v[230:231]
v_cvt_pk_bf16_f32 v44, v232, v233
v_cvt_pk_bf16_f32 v45, v234, v235
v_cvt_pk_bf16_f32 v46, v236, v237
v_cvt_pk_bf16_f32 v47, v238, v239
v_add_u32 v1, s32, v1
global_store_dwordx4 v1, v[44:47], s[10:11] offset:0 sc1
v_lshlrev_b32 v232, 16, v48
v_and_b32 v233, s19, v48
v_lshlrev_b32 v234, 16, v49
v_and_b32 v235, s19, v49
v_lshlrev_b32 v236, 16, v50
v_and_b32 v237, s19, v50
v_lshlrev_b32 v238, 16, v51
v_and_b32 v239, s19, v51
v_pk_mul_f32 v[232:233], v[232:233], v[224:225]
v_pk_mul_f32 v[234:235], v[234:235], v[226:227]
v_pk_mul_f32 v[236:237], v[236:237], v[228:229]
v_pk_mul_f32 v[238:239], v[238:239], v[230:231]
v_cvt_pk_bf16_f32 v48, v232, v233
v_cvt_pk_bf16_f32 v49, v234, v235
v_cvt_pk_bf16_f32 v50, v236, v237
v_cvt_pk_bf16_f32 v51, v238, v239
v_add_u32 v1, s33, v1
global_store_dwordx4 v1, v[48:51], s[10:11] offset:-3072 sc1
v_lshlrev_b32 v232, 16, v52
v_and_b32 v233, s19, v52
v_lshlrev_b32 v234, 16, v53
v_and_b32 v235, s19, v53
v_lshlrev_b32 v236, 16, v54
v_and_b32 v237, s19, v54
v_lshlrev_b32 v238, 16, v55
v_and_b32 v239, s19, v55
v_pk_mul_f32 v[232:233], v[232:233], v[224:225]
v_pk_mul_f32 v[234:235], v[234:235], v[226:227]
v_pk_mul_f32 v[236:237], v[236:237], v[228:229]
v_pk_mul_f32 v[238:239], v[238:239], v[230:231]
v_cvt_pk_bf16_f32 v52, v232, v233
v_cvt_pk_bf16_f32 v53, v234, v235
v_cvt_pk_bf16_f32 v54, v236, v237
v_cvt_pk_bf16_f32 v55, v238, v239
global_store_dwordx4 v1, v[52:55], s[10:11] offset:0 sc1
v_lshlrev_b32 v232, 16, v56
v_and_b32 v233, s19, v56
v_lshlrev_b32 v234, 16, v57
v_and_b32 v235, s19, v57
v_lshlrev_b32 v236, 16, v58
v_and_b32 v237, s19, v58
v_lshlrev_b32 v238, 16, v59
v_and_b32 v239, s19, v59
v_pk_mul_f32 v[232:233], v[232:233], v[224:225]
v_pk_mul_f32 v[234:235], v[234:235], v[226:227]
v_pk_mul_f32 v[236:237], v[236:237], v[228:229]
v_pk_mul_f32 v[238:239], v[238:239], v[230:231]
v_cvt_pk_bf16_f32 v56, v232, v233
v_cvt_pk_bf16_f32 v57, v234, v235
v_cvt_pk_bf16_f32 v58, v236, v237
v_cvt_pk_bf16_f32 v59, v238, v239
global_store_dwordx4 v1, v[56:59], s[10:11] offset:3072 sc1
v_lshlrev_b32 v232, 16, v60
v_and_b32 v233, s19, v60
v_lshlrev_b32 v234, 16, v61
v_and_b32 v235, s19, v61
v_lshlrev_b32 v236, 16, v62
v_and_b32 v237, s19, v62
v_lshlrev_b32 v238, 16, v63
v_and_b32 v239, s19, v63
v_pk_mul_f32 v[232:233], v[232:233], v[224:225]
v_pk_mul_f32 v[234:235], v[234:235], v[226:227]
v_pk_mul_f32 v[236:237], v[236:237], v[228:229]
v_pk_mul_f32 v[238:239], v[238:239], v[230:231]
v_cvt_pk_bf16_f32 v60, v232, v233
v_cvt_pk_bf16_f32 v61, v234, v235
v_cvt_pk_bf16_f32 v62, v236, v237
v_cvt_pk_bf16_f32 v63, v238, v239
v_add_u32 v1, s32, v1
global_store_dwordx4 v1, v[60:63], s[10:11] offset:0 sc1
v_lshlrev_b32 v232, 16, v64
v_and_b32 v233, s19, v64
v_lshlrev_b32 v234, 16, v65
v_and_b32 v235, s19, v65
v_lshlrev_b32 v236, 16, v66
v_and_b32 v237, s19, v66
v_lshlrev_b32 v238, 16, v67
v_and_b32 v239, s19, v67
v_pk_mul_f32 v[232:233], v[232:233], v[224:225]
v_pk_mul_f32 v[234:235], v[234:235], v[226:227]
v_pk_mul_f32 v[236:237], v[236:237], v[228:229]
v_pk_mul_f32 v[238:239], v[238:239], v[230:231]
v_cvt_pk_bf16_f32 v64, v232, v233
v_cvt_pk_bf16_f32 v65, v234, v235
v_cvt_pk_bf16_f32 v66, v236, v237
v_cvt_pk_bf16_f32 v67, v238, v239
v_add_u32 v1, s33, v1
global_store_dwordx4 v1, v[64:67], s[10:11] offset:-3072 sc1
v_lshlrev_b32 v232, 16, v68
v_and_b32 v233, s19, v68
v_lshlrev_b32 v234, 16, v69
v_and_b32 v235, s19, v69
v_lshlrev_b32 v236, 16, v70
v_and_b32 v237, s19, v70
v_lshlrev_b32 v238, 16, v71
v_and_b32 v239, s19, v71
v_pk_mul_f32 v[232:233], v[232:233], v[224:225]
v_pk_mul_f32 v[234:235], v[234:235], v[226:227]
v_pk_mul_f32 v[236:237], v[236:237], v[228:229]
v_pk_mul_f32 v[238:239], v[238:239], v[230:231]
v_cvt_pk_bf16_f32 v68, v232, v233
v_cvt_pk_bf16_f32 v69, v234, v235
v_cvt_pk_bf16_f32 v70, v236, v237
v_cvt_pk_bf16_f32 v71, v238, v239
global_store_dwordx4 v1, v[68:71], s[10:11] offset:0 sc1
v_lshlrev_b32 v232, 16, v72
v_and_b32 v233, s19, v72
v_lshlrev_b32 v234, 16, v73
v_and_b32 v235, s19, v73
v_lshlrev_b32 v236, 16, v74
v_and_b32 v237, s19, v74
v_lshlrev_b32 v238, 16, v75
v_and_b32 v239, s19, v75
v_pk_mul_f32 v[232:233], v[232:233], v[224:225]
v_pk_mul_f32 v[234:235], v[234:235], v[226:227]
v_pk_mul_f32 v[236:237], v[236:237], v[228:229]
v_pk_mul_f32 v[238:239], v[238:239], v[230:231]
v_cvt_pk_bf16_f32 v72, v232, v233
v_cvt_pk_bf16_f32 v73, v234, v235
v_cvt_pk_bf16_f32 v74, v236, v237
v_cvt_pk_bf16_f32 v75, v238, v239
global_store_dwordx4 v1, v[72:75], s[10:11] offset:3072 sc1
v_lshlrev_b32 v232, 16, v76
v_and_b32 v233, s19, v76
v_lshlrev_b32 v234, 16, v77
v_and_b32 v235, s19, v77
v_lshlrev_b32 v236, 16, v78
v_and_b32 v237, s19, v78
v_lshlrev_b32 v238, 16, v79
v_and_b32 v239, s19, v79
v_pk_mul_f32 v[232:233], v[232:233], v[224:225]
v_pk_mul_f32 v[234:235], v[234:235], v[226:227]
v_pk_mul_f32 v[236:237], v[236:237], v[228:229]
v_pk_mul_f32 v[238:239], v[238:239], v[230:231]
v_cvt_pk_bf16_f32 v76, v232, v233
v_cvt_pk_bf16_f32 v77, v234, v235
v_cvt_pk_bf16_f32 v78, v236, v237
v_cvt_pk_bf16_f32 v79, v238, v239
v_add_u32 v1, s32, v1
global_store_dwordx4 v1, v[76:79], s[10:11] offset:0 sc1
v_lshlrev_b32 v232, 16, v80
v_and_b32 v233, s19, v80
v_lshlrev_b32 v234, 16, v81
v_and_b32 v235, s19, v81
v_lshlrev_b32 v236, 16, v82
v_and_b32 v237, s19, v82
v_lshlrev_b32 v238, 16, v83
v_and_b32 v239, s19, v83
v_pk_mul_f32 v[232:233], v[232:233], v[224:225]
v_pk_mul_f32 v[234:235], v[234:235], v[226:227]
v_pk_mul_f32 v[236:237], v[236:237], v[228:229]
v_pk_mul_f32 v[238:239], v[238:239], v[230:231]
v_cvt_pk_bf16_f32 v80, v232, v233
v_cvt_pk_bf16_f32 v81, v234, v235
v_cvt_pk_bf16_f32 v82, v236, v237
v_cvt_pk_bf16_f32 v83, v238, v239
v_add_u32 v1, s33, v1
global_store_dwordx4 v1, v[80:83], s[10:11] offset:-3072 sc1
v_lshlrev_b32 v232, 16, v84
v_and_b32 v233, s19, v84
v_lshlrev_b32 v234, 16, v85
v_and_b32 v235, s19, v85
v_lshlrev_b32 v236, 16, v86
v_and_b32 v237, s19, v86
v_lshlrev_b32 v238, 16, v87
v_and_b32 v239, s19, v87
v_pk_mul_f32 v[232:233], v[232:233], v[224:225]
v_pk_mul_f32 v[234:235], v[234:235], v[226:227]
v_pk_mul_f32 v[236:237], v[236:237], v[228:229]
v_pk_mul_f32 v[238:239], v[238:239], v[230:231]
v_cvt_pk_bf16_f32 v84, v232, v233
v_cvt_pk_bf16_f32 v85, v234, v235
v_cvt_pk_bf16_f32 v86, v236, v237
v_cvt_pk_bf16_f32 v87, v238, v239
global_store_dwordx4 v1, v[84:87], s[10:11] offset:0 sc1
v_lshlrev_b32 v232, 16, v88
v_and_b32 v233, s19, v88
v_lshlrev_b32 v234, 16, v89
v_and_b32 v235, s19, v89
v_lshlrev_b32 v236, 16, v90
v_and_b32 v237, s19, v90
v_lshlrev_b32 v238, 16, v91
v_and_b32 v239, s19, v91
v_pk_mul_f32 v[232:233], v[232:233], v[224:225]
v_pk_mul_f32 v[234:235], v[234:235], v[226:227]
v_pk_mul_f32 v[236:237], v[236:237], v[228:229]
v_pk_mul_f32 v[238:239], v[238:239], v[230:231]
v_cvt_pk_bf16_f32 v88, v232, v233
v_cvt_pk_bf16_f32 v89, v234, v235
v_cvt_pk_bf16_f32 v90, v236, v237
v_cvt_pk_bf16_f32 v91, v238, v239
global_store_dwordx4 v1, v[88:91], s[10:11] offset:3072 sc1
v_lshlrev_b32 v232, 16, v92
v_and_b32 v233, s19, v92
v_lshlrev_b32 v234, 16, v93
v_and_b32 v235, s19, v93
v_lshlrev_b32 v236, 16, v94
v_and_b32 v237, s19, v94
v_lshlrev_b32 v238, 16, v95
v_and_b32 v239, s19, v95
v_pk_mul_f32 v[232:233], v[232:233], v[224:225]
v_pk_mul_f32 v[234:235], v[234:235], v[226:227]
v_pk_mul_f32 v[236:237], v[236:237], v[228:229]
v_pk_mul_f32 v[238:239], v[238:239], v[230:231]
v_cvt_pk_bf16_f32 v92, v232, v233
v_cvt_pk_bf16_f32 v93, v234, v235
v_cvt_pk_bf16_f32 v94, v236, v237
v_cvt_pk_bf16_f32 v95, v238, v239
v_add_u32 v1, s32, v1
global_store_dwordx4 v1, v[92:95], s[10:11] offset:0 sc1
v_lshlrev_b32 v232, 16, v96
v_and_b32 v233, s19, v96
v_lshlrev_b32 v234, 16, v97
v_and_b32 v235, s19, v97
v_lshlrev_b32 v236, 16, v98
v_and_b32 v237, s19, v98
v_lshlrev_b32 v238, 16, v99
v_and_b32 v239, s19, v99
v_pk_mul_f32 v[232:233], v[232:233], v[224:225]
v_pk_mul_f32 v[234:235], v[234:235], v[226:227]
v_pk_mul_f32 v[236:237], v[236:237], v[228:229]
v_pk_mul_f32 v[238:239], v[238:239], v[230:231]
v_cvt_pk_bf16_f32 v96, v232, v233
v_cvt_pk_bf16_f32 v97, v234, v235
v_cvt_pk_bf16_f32 v98, v236, v237
v_cvt_pk_bf16_f32 v99, v238, v239
v_add_u32 v1, s33, v1
global_store_dwordx4 v1, v[96:99], s[10:11] offset:-3072 sc1
v_lshlrev_b32 v232, 16, v100
v_and_b32 v233, s19, v100
v_lshlrev_b32 v234, 16, v101
v_and_b32 v235, s19, v101
v_lshlrev_b32 v236, 16, v102
v_and_b32 v237, s19, v102
v_lshlrev_b32 v238, 16, v103
v_and_b32 v239, s19, v103
v_pk_mul_f32 v[232:233], v[232:233], v[224:225]
v_pk_mul_f32 v[234:235], v[234:235], v[226:227]
v_pk_mul_f32 v[236:237], v[236:237], v[228:229]
v_pk_mul_f32 v[238:239], v[238:239], v[230:231]
v_cvt_pk_bf16_f32 v100, v232, v233
v_cvt_pk_bf16_f32 v101, v234, v235
v_cvt_pk_bf16_f32 v102, v236, v237
v_cvt_pk_bf16_f32 v103, v238, v239
global_store_dwordx4 v1, v[100:103], s[10:11] offset:0 sc1
v_lshlrev_b32 v232, 16, v104
v_and_b32 v233, s19, v104
v_lshlrev_b32 v234, 16, v105
v_and_b32 v235, s19, v105
v_lshlrev_b32 v236, 16, v106
v_and_b32 v237, s19, v106
v_lshlrev_b32 v238, 16, v107
v_and_b32 v239, s19, v107
v_pk_mul_f32 v[232:233], v[232:233], v[224:225]
v_pk_mul_f32 v[234:235], v[234:235], v[226:227]
v_pk_mul_f32 v[236:237], v[236:237], v[228:229]
v_pk_mul_f32 v[238:239], v[238:239], v[230:231]
v_cvt_pk_bf16_f32 v104, v232, v233
v_cvt_pk_bf16_f32 v105, v234, v235
v_cvt_pk_bf16_f32 v106, v236, v237
v_cvt_pk_bf16_f32 v107, v238, v239
global_store_dwordx4 v1, v[104:107], s[10:11] offset:3072 sc1
v_lshlrev_b32 v232, 16, v108
v_and_b32 v233, s19, v108
v_lshlrev_b32 v234, 16, v109
v_and_b32 v235, s19, v109
v_lshlrev_b32 v236, 16, v110
v_and_b32 v237, s19, v110
v_lshlrev_b32 v238, 16, v111
v_and_b32 v239, s19, v111
v_pk_mul_f32 v[232:233], v[232:233], v[224:225]
v_pk_mul_f32 v[234:235], v[234:235], v[226:227]
v_pk_mul_f32 v[236:237], v[236:237], v[228:229]
v_pk_mul_f32 v[238:239], v[238:239], v[230:231]
v_cvt_pk_bf16_f32 v108, v232, v233
v_cvt_pk_bf16_f32 v109, v234, v235
v_cvt_pk_bf16_f32 v110, v236, v237
v_cvt_pk_bf16_f32 v111, v238, v239
v_add_u32 v1, s32, v1
global_store_dwordx4 v1, v[108:111], s[10:11] offset:0 sc1
v_lshlrev_b32 v232, 16, v112
v_and_b32 v233, s19, v112
v_lshlrev_b32 v234, 16, v113
v_and_b32 v235, s19, v113
v_lshlrev_b32 v236, 16, v114
v_and_b32 v237, s19, v114
v_lshlrev_b32 v238, 16, v115
v_and_b32 v239, s19, v115
v_pk_mul_f32 v[232:233], v[232:233], v[224:225]
v_pk_mul_f32 v[234:235], v[234:235], v[226:227]
v_pk_mul_f32 v[236:237], v[236:237], v[228:229]
v_pk_mul_f32 v[238:239], v[238:239], v[230:231]
v_cvt_pk_bf16_f32 v112, v232, v233
v_cvt_pk_bf16_f32 v113, v234, v235
v_cvt_pk_bf16_f32 v114, v236, v237
v_cvt_pk_bf16_f32 v115, v238, v239
v_add_u32 v1, s33, v1
global_store_dwordx4 v1, v[112:115], s[10:11] offset:-3072 sc1
v_lshlrev_b32 v232, 16, v116
v_and_b32 v233, s19, v116
v_lshlrev_b32 v234, 16, v117
v_and_b32 v235, s19, v117
v_lshlrev_b32 v236, 16, v118
v_and_b32 v237, s19, v118
v_lshlrev_b32 v238, 16, v119
v_and_b32 v239, s19, v119
v_pk_mul_f32 v[232:233], v[232:233], v[224:225]
v_pk_mul_f32 v[234:235], v[234:235], v[226:227]
v_pk_mul_f32 v[236:237], v[236:237], v[228:229]
v_pk_mul_f32 v[238:239], v[238:239], v[230:231]
v_cvt_pk_bf16_f32 v116, v232, v233
v_cvt_pk_bf16_f32 v117, v234, v235
v_cvt_pk_bf16_f32 v118, v236, v237
v_cvt_pk_bf16_f32 v119, v238, v239
global_store_dwordx4 v1, v[116:119], s[10:11] offset:0 sc1
v_lshlrev_b32 v232, 16, v120
v_and_b32 v233, s19, v120
v_lshlrev_b32 v234, 16, v121
v_and_b32 v235, s19, v121
v_lshlrev_b32 v236, 16, v122
v_and_b32 v237, s19, v122
v_lshlrev_b32 v238, 16, v123
v_and_b32 v239, s19, v123
v_pk_mul_f32 v[232:233], v[232:233], v[224:225]
v_pk_mul_f32 v[234:235], v[234:235], v[226:227]
v_pk_mul_f32 v[236:237], v[236:237], v[228:229]
v_pk_mul_f32 v[238:239], v[238:239], v[230:231]
v_cvt_pk_bf16_f32 v120, v232, v233
v_cvt_pk_bf16_f32 v121, v234, v235
v_cvt_pk_bf16_f32 v122, v236, v237
v_cvt_pk_bf16_f32 v123, v238, v239
global_store_dwordx4 v1, v[120:123], s[10:11] offset:3072 sc1
v_lshlrev_b32 v232, 16, v124
v_and_b32 v233, s19, v124
v_lshlrev_b32 v234, 16, v125
v_and_b32 v235, s19, v125
v_lshlrev_b32 v236, 16, v126
v_and_b32 v237, s19, v126
v_lshlrev_b32 v238, 16, v127
v_and_b32 v239, s19, v127
v_pk_mul_f32 v[232:233], v[232:233], v[224:225]
v_pk_mul_f32 v[234:235], v[234:235], v[226:227]
v_pk_mul_f32 v[236:237], v[236:237], v[228:229]
v_pk_mul_f32 v[238:239], v[238:239], v[230:231]
v_cvt_pk_bf16_f32 v124, v232, v233
v_cvt_pk_bf16_f32 v125, v234, v235
v_cvt_pk_bf16_f32 v126, v236, v237
v_cvt_pk_bf16_f32 v127, v238, v239
v_add_u32 v1, s32, v1
global_store_dwordx4 v1, v[124:127], s[10:11] offset:0 sc1
L_end:
s_endpgm
L_fb:
s_waitcnt vmcnt(0)
s_mov_b32 exec_lo, 0x00ff00ff
s_mov_b32 exec_hi, 0x00ff00ff
global_store_dwordx4 v9, v[252:255], s[14:15] sc1
s_mov_b64 exec, -1
v_add_u32 v12, 2048, v12
s_branch L_fbdone
L_red:
v_mov_b32 v39, 851968
s_and_b32 s27, s2, 7
s_mov_b32 s22, 0x07060302
s_waitcnt lgkmcnt(0)
global_load_dword v15, v39, s[14:15]
s_cmp_lt_u32 s2, 8
s_cbranch_scc1 L_mlp
s_cmp_eq_u32 s3, 2
s_cbranch_scc1 L_end
s_lshr_b32 s16, s2, 3
s_lshl_b32 s16, s16, 1
s_add_u32 s16, s16, s3
s_lshl_b32 s16, s16, 8
s_mul_i32 s17, s27, 49152
s_add_u32 s17, s17, s16
s_add_u32 s17, s17, 2816
s_mul_i32 s18, s27, 1536
s_add_u32 s18, s18, s16
s_add_u32 s18, s18, 523776
v_lshrrev_b32 v4, 4, v2
v_and_b32 v6, 15, v2
v_lshl_add_u32 v8, v6, 4, s17
v_lshl_add_u32 v7, v6, 4, s18
v_mul_u32_u24 v6, 1664, v4
v_add_u32 v8, v8, v6
v_mul_u32_u24 v6, 12416, v4
v_add_u32 v7, v7, v6
v_add_u32 v6, 49664, v7
v_add_u32 v9, 13312, v8
v_add_u32 v10, 26624, v8
v_add_u32 v11, 39936, v8
s_mov_b32 s21, 1048576
global_load_dwordx4 v[16:19], v8, s[14:15] offset:-3328 sc1
global_load_dwordx4 v[20:23], v8, s[14:15] offset:3328 sc1
global_load_dwordx4 v[24:27], v9, s[14:15] offset:-3328 sc1
global_load_dwordx4 v[28:31], v9, s[14:15] offset:3328 sc1
global_load_dwordx4 v[32:35], v10, s[14:15] offset:-3328 sc1
global_load_dwordx4 v[36:39], v10, s[14:15] offset:3328 sc1
global_load_dwordx4 v[40:43], v11, s[14:15] offset:-3328 sc1
s_waitcnt vmcnt(7)
v_add_u32 v15, 0x9e3779b1, v15
s_branch L_chk1
L_poll1:
global_load_dwordx4 v[16:19], v8, s[14:15] offset:-3328 sc1
global_load_dwordx4 v[20:23], v8, s[14:15] offset:3328 sc1
global_load_dwordx4 v[24:27], v9, s[14:15] offset:-3328 sc1
global_load_dwordx4 v[28:31], v9, s[14:15] offset:3328 sc1
global_load_dwordx4 v[32:35], v10, s[14:15] offset:-3328 sc1
global_load_dwordx4 v[36:39], v10, s[14:15] offset:3328 sc1
global_load_dwordx4 v[40:43], v11, s[14:15] offset:-3328 sc1
s_sub_u32 s21, s21, 1
s_cbranch_scc1 L_poll1done
L_chk1:
s_waitcnt vmcnt(5)
v_bitop3_b32 v12, v19, v23, v15 bitop3:0x7e
s_waitcnt vmcnt(3)
v_bitop3_b32 v13, v27, v31, v15 bitop3:0x7e
s_waitcnt vmcnt(1)
v_bitop3_b32 v14, v35, v39, v15 bitop3:0x7e
v_or3_b32 v12, v12, v13, v14
s_waitcnt vmcnt(0)
v_bitop3_b32 v12, v43, v15, v12 bitop3:0xbe
v_cmpx_ne_u32 vcc, 0, v12
s_cbranch_vccnz L_poll1
L_poll1done:
s_mov_b64 exec, -1
v_pk_add_f32 v[48:49], v[16:17], v[20:21]
v_pk_add_f32 v[52:53], v[24:25], v[28:29]
v_lshlrev_b32 v54, 16, v18
v_lshlrev_b32 v55, 16, v22
v_lshlrev_b32 v56, 16, v26
v_lshlrev_b32 v57, 16, v30
v_lshlrev_b32 v58, 16, v34
v_lshlrev_b32 v59, 16, v38
v_lshlrev_b32 v60, 16, v42
v_pk_add_f32 v[48:49], v[48:49], v[32:33]
v_pk_add_f32 v[52:53], v[52:53], v[36:37]
v_max3_f32 v50, v18, v22, v26
v_max3_f32 v51, v54, v55, v56
v_pk_add_f32 v[48:49], v[48:49], v[40:41]
v_max3_f32 v50, v50, v30, v34
v_max3_f32 v51, v51, v57, v58
v_pk_add_f32 v[48:49], v[48:49], v[52:53]
v_max3_f32 v50, v50, v38, v42
v_max3_f32 v51, v51, v59, v60
v_permlane32_swap_b32 v48, v49
v_add_f32 v12, v48, v49
v_permlane32_swap_b32 v51, v50
v_add_f32 v13, v48, v49
v_max_f32 v8, v50, v51
v_max_f32 v9, v50, v51
v_permlane16_swap_b32 v12, v13
v_add_f32 v12, v12, v13
v_permlane16_swap_b32 v8, v9
v_mov_b32 v13, v12
v_max_f32 v10, v8, v9
v_max_f32 v11, v8, v9
v_permlane32_swap_b32 v12, v13
s_nop 0
v_permlane32_swap_b32 v10, v11
v_perm_b32 v14, v11, v10, s22
global_store_dwordx4 v7, v[12:15], s[14:15] sc1
global_store_dwordx4 v6, v[12:15], s[14:15] sc1
s_endpgm
L_mlp:
v_and_b32 v12, 31, v2
v_lshl_add_u32 v12, v3, 5, v12
v_lshrrev_b32 v14, 5, v2
v_mul_u32_u24 v14, 384, v14
v_lshl_add_u32 v34, v12, 2, v14
v_add_lshl_u32 v12, v12, v14, 4
s_mul_i32 s28, s27, 12416
s_add_u32 s28, s28, 527360
v_add_u32 v36, s28, v12
s_mul_i32 s24, s3, 6144
v_lshl_add_u32 v12, v2, 4, s24
s_mov_b32 m0, s24
v_add_u32 v13, 3072, v12
global_load_lds_dwordx4 v12, s[6:7] offset:0
global_load_lds_dwordx4 v12, s[6:7] offset:1024
global_load_lds_dwordx4 v12, s[6:7] offset:2048
s_add_u32 m0, m0, 3072
v_lshrrev_b32 v14, 4, v2
global_load_lds_dwordx4 v13, s[6:7] offset:0
global_load_lds_dwordx4 v13, s[6:7] offset:1024
global_load_lds_dwordx4 v13, s[6:7] offset:2048
v_mul_u32_u24 v12, 1536, v14
v_lshl_add_u32 v12, v3, 7, v12
v_and_b32 v13, 7, v2
v_lshl_add_u32 v12, v13, 4, v12
v_and_b32 v13, 8, v2
v_add_u32 v12, v12, v13
global_load_dwordx2 v[48:49], v12, s[8:9] offset:0
global_load_dwordx2 v[50:51], v12, s[8:9] offset:384
global_load_dwordx2 v[52:53], v12, s[8:9] offset:768
global_load_dwordx2 v[54:55], v12, s[8:9] offset:1152
v_add_u32 v12, 6144, v12
global_load_dwordx2 v[56:57], v12, s[8:9] offset:0
global_load_dwordx2 v[58:59], v12, s[8:9] offset:384
global_load_dwordx2 v[60:61], v12, s[8:9] offset:768
global_load_dwordx2 v[62:63], v12, s[8:9] offset:1152
v_add_u32 v12, 6144, v12
global_load_dwordx2 v[64:65], v12, s[8:9] offset:0
global_load_dwordx2 v[66:67], v12, s[8:9] offset:384
global_load_dwordx2 v[68:69], v12, s[8:9] offset:768
global_load_dwordx2 v[70:71], v12, s[8:9] offset:1152
s_lshl_b32 s28, s27, 12
s_add_u32 s28, s28, 655360
v_lshl_add_u32 v37, v0, 2, s28
global_load_dword v5, v37, s[14:15] sc1
global_load_dwordx4 v[224:227], v36, s[14:15] offset:-3072 sc1
global_load_dwordx4 v[228:231], v36, s[14:15] offset:-1536 sc1
global_load_dwordx4 v[232:235], v36, s[14:15] offset:0 sc1
global_load_dwordx4 v[236:239], v36, s[14:15] offset:1536 sc1
v_bfe_u32 v12, v2, 3, 1
v_bfe_u32 v13, v2, 2, 1
v_lshl_add_u32 v12, v12, 3, v13
v_lshl_add_u32 v12, v14, 1, v12
v_mul_u32_u24 v12, 96, v12
v_and_b32 v13, 3, v2
v_lshl_add_u32 v32, v13, 3, v12
v_and_b32 v12, 1, v2
v_mul_u32_u24 v12, 384, v12
v_lshl_add_u32 v35, v14, 4, v12
s_mov_b32 s23, 0x05040100
s_mov_b32 s20, 0x37a72f05
s_mov_b32 s19, 0xffff0000
v_lshl_add_u32 v12, s27, 2, v39
v_lshl_add_u32 v33, v2, 2, v39
s_waitcnt vmcnt(5)
s_barrier
v_add_u32 v15, 0x9e3779b1, v15
s_mov_b64 exec, 1
global_store_dword v12, v15, s[14:15] offset:256 sc1
s_mov_b64 exec, -1
ds_read_b64_tr_b16 v[128:129], v32 offset:0
ds_read_b64_tr_b16 v[130:131], v32 offset:1536
ds_read_b64_tr_b16 v[132:133], v32 offset:32
ds_read_b64_tr_b16 v[134:135], v32 offset:1568
ds_read_b64_tr_b16 v[136:137], v32 offset:64
ds_read_b64_tr_b16 v[138:139], v32 offset:1600
ds_read_b64_tr_b16 v[140:141], v32 offset:3072
ds_read_b64_tr_b16 v[142:143], v32 offset:4608
ds_read_b64_tr_b16 v[144:145], v32 offset:3104
ds_read_b64_tr_b16 v[146:147], v32 offset:4640
ds_read_b64_tr_b16 v[148:149], v32 offset:3136
ds_read_b64_tr_b16 v[150:151], v32 offset:4672
ds_read_b64_tr_b16 v[152:153], v32 offset:6144
ds_read_b64_tr_b16 v[154:155], v32 offset:7680
ds_read_b64_tr_b16 v[156:157], v32 offset:6176
ds_read_b64_tr_b16 v[158:159], v32 offset:7712
ds_read_b64_tr_b16 v[160:161], v32 offset:6208
ds_read_b64_tr_b16 v[162:163], v32 offset:7744
ds_read_b64_tr_b16 v[164:165], v32 offset:9216
ds_read_b64_tr_b16 v[166:167], v32 offset:10752
ds_read_b64_tr_b16 v[168:169], v32 offset:9248
ds_read_b64_tr_b16 v[170:171], v32 offset:10784
ds_read_b64_tr_b16 v[172:173], v32 offset:9280
ds_read_b64_tr_b16 v[174:175], v32 offset:10816
ds_read_b64_tr_b16 v[176:177], v32 offset:12288
ds_read_b64_tr_b16 v[178:179], v32 offset:13824
ds_read_b64_tr_b16 v[180:181], v32 offset:12320
ds_read_b64_tr_b16 v[182:183], v32 offset:13856
ds_read_b64_tr_b16 v[184:185], v32 offset:12352
ds_read_b64_tr_b16 v[186:187], v32 offset:13888
ds_read_b64_tr_b16 v[188:189], v32 offset:15360
ds_read_b64_tr_b16 v[190:191], v32 offset:16896
ds_read_b64_tr_b16 v[192:193], v32 offset:15392
ds_read_b64_tr_b16 v[194:195], v32 offset:16928
ds_read_b64_tr_b16 v[196:197], v32 offset:15424
ds_read_b64_tr_b16 v[198:199], v32 offset:16960
v_perm_b32 v200, v50, v48, s23
v_perm_b32 v201, v54, v52, s23
v_perm_b32 v202, v58, v56, s23
v_perm_b32 v203, v62, v60, s23
v_perm_b32 v204, v66, v64, s23
v_perm_b32 v205, v70, v68, s23
v_perm_b32 v206, v50, v48, s22
v_perm_b32 v207, v54, v52, s22
v_perm_b32 v208, v58, v56, s22
v_perm_b32 v209, v62, v60, s22
v_perm_b32 v210, v66, v64, s22
v_perm_b32 v211, v70, v68, s22
v_perm_b32 v212, v51, v49, s23
v_perm_b32 v213, v55, v53, s23
v_perm_b32 v214, v59, v57, s23
v_perm_b32 v215, v63, v61, s23
v_perm_b32 v216, v67, v65, s23
v_perm_b32 v217, v71, v69, s23
v_perm_b32 v218, v51, v49, s22
v_perm_b32 v219, v55, v53, s22
v_perm_b32 v220, v59, v57, s22
v_perm_b32 v221, v63, v61, s22
v_perm_b32 v222, v67, v65, s22
v_perm_b32 v223, v71, v69, s22
s_waitcnt vmcnt(1)
v_and_b32 v38, 0xffff, v15
s_mov_b32 s21, 1048576
s_mov_b64 s[40:41], -1
s_mov_b64 s[42:43], -1
s_mov_b64 s[44:45], -1
s_mov_b64 s[46:47], -1
L_poll2:
global_load_dwordx4 v[224:227], v36, s[14:15] offset:-3072 sc1
global_load_dwordx4 v[228:231], v36, s[14:15] offset:-1536 sc1
global_load_dwordx4 v[232:235], v36, s[14:15] offset:0 sc1
global_load_dwordx4 v[236:239], v36, s[14:15] offset:1536 sc1
s_sub_u32 s21, s21, 1
s_cbranch_scc1 L_poll2done
s_waitcnt vmcnt(2)
v_bitop3_b32 v8, v227, v231, v15 bitop3:0x7e
s_waitcnt vmcnt(0)
v_bitop3_b32 v9, v235, v239, v15 bitop3:0x7e
v_or_b32 v8, v8, v9
v_cmpx_ne_u32 vcc, 0, v8
s_cbranch_vccnz L_poll2
L_poll2done:
s_mov_b64 exec, -1
v_pk_add_f32 v[16:17], v[224:225], v[228:229]
v_pk_add_f32 v[20:21], v[232:233], v[236:237]
v_lshlrev_b32 v22, 16, v226
v_lshlrev_b32 v23, 16, v230
v_lshlrev_b32 v24, 16, v234
v_lshlrev_b32 v25, 16, v238
v_max3_f32 v18, v226, v230, v234
v_max3_f32 v19, v22, v23, v24
v_pk_add_f32 v[16:17], v[16:17], v[20:21]
v_max_f32 v18, v18, v238
v_max_f32 v19, v19, v25
v_permlane32_swap_b32 v16, v17
v_add_f32 v16, v16, v17
v_permlane32_swap_b32 v19, v18
v_max_f32 v18, v18, v19
v_mul_f32 v16, s20, v16
v_and_b32 v18, s19, v18
s_nop 1
v_permlane32_swap_b32 v16, v18
v_cvt_pk_bf16_f32 v16, v16, v18
ds_write_b32 v34, v16 offset:18432
s_waitcnt lgkmcnt(0)
s_barrier
ds_read_b128 v[40:43], v35 offset:18432
ds_read_b128 v[44:47], v35 offset:18496
ds_read_b128 v[48:51], v35 offset:18560
ds_read_b128 v[52:55], v35 offset:18624
ds_read_b128 v[56:59], v35 offset:18688
ds_read_b128 v[60:63], v35 offset:18752
s_waitcnt lgkmcnt(5)
v_mfma_f32_16x16x32_bf16 v[244:247], v[128:131], v[40:43], 0
v_mfma_f32_16x16x32_bf16 v[248:251], v[132:135], v[40:43], 0
v_mfma_f32_16x16x32_bf16 v[252:255], v[136:139], v[40:43], 0
s_waitcnt lgkmcnt(4)
v_mfma_f32_16x16x32_bf16 v[244:247], v[140:143], v[44:47], v[244:247]
v_mfma_f32_16x16x32_bf16 v[248:251], v[144:147], v[44:47], v[248:251]
v_mfma_f32_16x16x32_bf16 v[252:255], v[148:151], v[44:47], v[252:255]
s_waitcnt lgkmcnt(3)
v_mfma_f32_16x16x32_bf16 v[244:247], v[152:155], v[48:51], v[244:247]
s_waitcnt lgkmcnt(2)
v_mfma_f32_16x16x32_bf16 v[244:247], v[164:167], v[52:55], v[244:247]
s_waitcnt lgkmcnt(1)
v_mfma_f32_16x16x32_bf16 v[244:247], v[176:179], v[56:59], v[244:247]
s_waitcnt lgkmcnt(0)
v_mfma_f32_16x16x32_bf16 v[244:247], v[188:191], v[60:63], v[244:247]
v_mfma_f32_16x16x32_bf16 v[248:251], v[156:159], v[48:51], v[248:251]
s_nop 1
v_mfma_f32_16x16x32_bf16 v[248:251], v[168:171], v[52:55], v[248:251]
s_nop 1
v_mfma_f32_16x16x32_bf16 v[248:251], v[180:183], v[56:59], v[248:251]
s_nop 0
v_mfma_f32_16x16x32_bf16 v[248:251], v[192:195], v[60:63], v[248:251]
v_cvt_pk_bf16_f32 v128, v244, v245
v_cvt_pk_bf16_f32 v129, v246, v247
v_mfma_f32_16x16x32_bf16 v[252:255], v[160:163], v[48:51], v[252:255]
v_pk_max_i16 v128, v128, 0
v_pk_max_i16 v129, v129, 0
v_mfma_f32_16x16x32_bf16 v[252:255], v[172:175], v[52:55], v[252:255]
s_nop 0
v_mfma_f32_16x16x32_bf16 v[252:255], v[184:187], v[56:59], v[252:255]
v_cvt_pk_bf16_f32 v130, v248, v249
v_cvt_pk_bf16_f32 v131, v250, v251
v_mfma_f32_16x16x32_bf16 v[252:255], v[196:199], v[60:63], v[252:255]
v_pk_max_i16 v130, v130, 0
v_pk_max_i16 v131, v131, 0
s_nop 1
v_mfma_f32_16x16x32_bf16 v[136:139], v[128:131], v[200:203], 0
s_nop 0
v_mfma_f32_16x16x32_bf16 v[140:143], v[128:131], v[206:209], 0
s_nop 0
v_cvt_pk_bf16_f32 v132, v252, v253
v_cvt_pk_bf16_f32 v133, v254, v255
v_mfma_f32_16x16x32_bf16 v[144:147], v[128:131], v[212:215], 0
v_pk_max_i16 v132, v132, 0
v_pk_max_i16 v133, v133, 0
v_mfma_f32_16x16x32_bf16 v[148:151], v[128:131], v[218:221], 0
s_nop 0
v_mfma_f32_16x16x16_bf16 v[136:139], v[132:133], v[204:205], v[136:139]
s_nop 1
v_mfma_f32_16x16x16_bf16 v[140:143], v[132:133], v[210:211], v[140:143]
s_nop 1
v_mfma_f32_16x16x16_bf16 v[144:147], v[132:133], v[216:217], v[144:147]
s_nop 0
v_mfma_f32_16x16x16_bf16 v[148:151], v[132:133], v[222:223], v[148:151]
v_cvt_pk_bf16_f32 v152, v136, v137
s_mov_b32 exec_lo, s19
s_nop 0
v_cvt_pk_bf16_f32 v152, v140, v141
s_mov_b32 exec_lo, 0
s_nop 0
v_cvt_pk_bf16_f32 v152, v144, v145
s_mov_b32 exec_hi, s19
v_cvt_pk_bf16_f32 v152, v148, v149
s_mov_b64 exec, -1
v_lshlrev_b32 v153, 16, v152
v_and_b32 v152, s19, v152
v_add_f32 v152, v152, v153
v_cvt_pk_bf16_f32 v152, 0, v152
v_mul_f32 v152, 0xbfb8aa3b, v152
v_exp_f32 v152, v152
s_nop 0
v_add_f32 v152, 1.0, v152
v_rcp_f32 v152, v152
s_nop 0
v_cvt_pk_bf16_f32 v152, 0, v152
v_or_b32 v152, v152, v38
global_store_dword v37, v152, s[14:15]
global_store_dword v37, v152, s[14:15] offset:2048 sc1
s_or_b32 s23, s2, s3
s_cbranch_scc1 L_nobump
s_mov_b32 s25, 1048576
s_mov_b64 exec, 0xff
L_tok:
global_load_dword v12, v33, s[14:15] offset:256 sc1
s_sub_u32 s25, s25, 1
s_cbranch_scc1 L_tokdone
s_waitcnt vmcnt(0)
v_cmp_ne_u32 vcc, v12, v15
s_cbranch_vccnz L_tok
L_tokdone:
s_mov_b64 exec, 1
global_store_dword v39, v15, s[14:15] sc1
L_nobump:
s_endpgm
L_exact:
v_lshlrev_b32 v240, 16, v16
v_lshlrev_b32 v244, 16, v20
v_lshlrev_b32 v241, 16, v17
v_lshlrev_b32 v245, 16, v21
v_lshlrev_b32 v242, 16, v18
v_lshlrev_b32 v246, 16, v22
v_lshlrev_b32 v243, 16, v19
v_lshlrev_b32 v247, 16, v23
v_maximum3_f32 v232, v240, v240, v244
v_maximum3_f32 v233, v241, v241, v245
v_maximum3_f32 v234, v242, v242, v246
v_maximum3_f32 v235, v243, v243, v247
v_and_b32 v240, s19, v16
v_and_b32 v244, s19, v20
v_and_b32 v241, s19, v17
v_and_b32 v245, s19, v21
v_and_b32 v242, s19, v18
v_and_b32 v246, s19, v22
v_and_b32 v243, s19, v19
v_and_b32 v247, s19, v23
v_maximum3_f32 v236, v240, v240, v244
v_maximum3_f32 v237, v241, v241, v245
v_maximum3_f32 v238, v242, v242, v246
v_maximum3_f32 v239, v243, v243, v247
v_lshlrev_b32 v240, 16, v24
v_lshlrev_b32 v244, 16, v28
v_lshlrev_b32 v241, 16, v25
v_lshlrev_b32 v245, 16, v29
v_lshlrev_b32 v242, 16, v26
v_lshlrev_b32 v246, 16, v30
v_lshlrev_b32 v243, 16, v27
v_lshlrev_b32 v247, 16, v31
v_maximum3_f32 v232, v232, v240, v244
v_maximum3_f32 v233, v233, v241, v245
v_maximum3_f32 v234, v234, v242, v246
v_maximum3_f32 v235, v235, v243, v247
v_and_b32 v240, s19, v24
v_and_b32 v244, s19, v28
v_and_b32 v241, s19, v25
v_and_b32 v245, s19, v29
v_and_b32 v242, s19, v26
v_and_b32 v246, s19, v30
v_and_b32 v243, s19, v27
v_and_b32 v247, s19, v31
v_maximum3_f32 v236, v236, v240, v244
v_maximum3_f32 v237, v237, v241, v245
v_maximum3_f32 v238, v238, v242, v246
v_maximum3_f32 v239, v239, v243, v247
v_lshlrev_b32 v240, 16, v32
v_lshlrev_b32 v244, 16, v36
v_lshlrev_b32 v241, 16, v33
v_lshlrev_b32 v245, 16, v37
v_lshlrev_b32 v242, 16, v34
v_lshlrev_b32 v246, 16, v38
v_lshlrev_b32 v243, 16, v35
v_lshlrev_b32 v247, 16, v39
v_maximum3_f32 v232, v232, v240, v244
v_maximum3_f32 v233, v233, v241, v245
v_maximum3_f32 v234, v234, v242, v246
v_maximum3_f32 v235, v235, v243, v247
v_and_b32 v240, s19, v32
v_and_b32 v244, s19, v36
v_and_b32 v241, s19, v33
v_and_b32 v245, s19, v37
v_and_b32 v242, s19, v34
v_and_b32 v246, s19, v38
v_and_b32 v243, s19, v35
v_and_b32 v247, s19, v39
v_maximum3_f32 v236, v236, v240, v244
v_maximum3_f32 v237, v237, v241, v245
v_maximum3_f32 v238, v238, v242, v246
v_maximum3_f32 v239, v239, v243, v247
v_lshlrev_b32 v240, 16, v40
v_lshlrev_b32 v244, 16, v44
v_lshlrev_b32 v241, 16, v41
v_lshlrev_b32 v245, 16, v45
v_lshlrev_b32 v242, 16, v42
v_lshlrev_b32 v246, 16, v46
v_lshlrev_b32 v243, 16, v43
v_lshlrev_b32 v247, 16, v47
v_maximum3_f32 v232, v232, v240, v244
v_maximum3_f32 v233, v233, v241, v245
v_maximum3_f32 v234, v234, v242, v246
v_maximum3_f32 v235, v235, v243, v247
v_and_b32 v240, s19, v40
v_and_b32 v244, s19, v44
v_and_b32 v241, s19, v41
v_and_b32 v245, s19, v45
v_and_b32 v242, s19, v42
v_and_b32 v246, s19, v46
v_and_b32 v243, s19, v43
v_and_b32 v247, s19, v47
v_maximum3_f32 v236, v236, v240, v244
v_maximum3_f32 v237, v237, v241, v245
v_maximum3_f32 v238, v238, v242, v246
v_maximum3_f32 v239, v239, v243, v247
v_lshlrev_b32 v240, 16, v48
v_lshlrev_b32 v244, 16, v52
v_lshlrev_b32 v241, 16, v49
v_lshlrev_b32 v245, 16, v53
v_lshlrev_b32 v242, 16, v50
v_lshlrev_b32 v246, 16, v54
v_lshlrev_b32 v243, 16, v51
v_lshlrev_b32 v247, 16, v55
v_maximum3_f32 v232, v232, v240, v244
v_maximum3_f32 v233, v233, v241, v245
v_maximum3_f32 v234, v234, v242, v246
v_maximum3_f32 v235, v235, v243, v247
v_and_b32 v240, s19, v48
v_and_b32 v244, s19, v52
v_and_b32 v241, s19, v49
v_and_b32 v245, s19, v53
v_and_b32 v242, s19, v50
v_and_b32 v246, s19, v54
v_and_b32 v243, s19, v51
v_and_b32 v247, s19, v55
v_maximum3_f32 v236, v236, v240, v244
v_maximum3_f32 v237, v237, v241, v245
v_maximum3_f32 v238, v238, v242, v246
v_maximum3_f32 v239, v239, v243, v247
v_lshlrev_b32 v240, 16, v56
v_lshlrev_b32 v244, 16, v60
v_lshlrev_b32 v241, 16, v57
v_lshlrev_b32 v245, 16, v61
v_lshlrev_b32 v242, 16, v58
v_lshlrev_b32 v246, 16, v62
v_lshlrev_b32 v243, 16, v59
v_lshlrev_b32 v247, 16, v63
v_maximum3_f32 v232, v232, v240, v244
v_maximum3_f32 v233, v233, v241, v245
v_maximum3_f32 v234, v234, v242, v246
v_maximum3_f32 v235, v235, v243, v247
v_and_b32 v240, s19, v56
v_and_b32 v244, s19, v60
v_and_b32 v241, s19, v57
v_and_b32 v245, s19, v61
v_and_b32 v242, s19, v58
v_and_b32 v246, s19, v62
v_and_b32 v243, s19, v59
v_and_b32 v247, s19, v63
v_maximum3_f32 v236, v236, v240, v244
v_maximum3_f32 v237, v237, v241, v245
v_maximum3_f32 v238, v238, v242, v246
v_maximum3_f32 v239, v239, v243, v247
v_lshlrev_b32 v240, 16, v64
v_lshlrev_b32 v244, 16, v68
v_lshlrev_b32 v241, 16, v65
v_lshlrev_b32 v245, 16, v69
v_lshlrev_b32 v242, 16, v66
v_lshlrev_b32 v246, 16, v70
v_lshlrev_b32 v243, 16, v67
v_lshlrev_b32 v247, 16, v71
v_maximum3_f32 v232, v232, v240, v244
v_maximum3_f32 v233, v233, v241, v245
v_maximum3_f32 v234, v234, v242, v246
v_maximum3_f32 v235, v235, v243, v247
v_and_b32 v240, s19, v64
v_and_b32 v244, s19, v68
v_and_b32 v241, s19, v65
v_and_b32 v245, s19, v69
v_and_b32 v242, s19, v66
v_and_b32 v246, s19, v70
v_and_b32 v243, s19, v67
v_and_b32 v247, s19, v71
v_maximum3_f32 v236, v236, v240, v244
v_maximum3_f32 v237, v237, v241, v245
v_maximum3_f32 v238, v238, v242, v246
v_maximum3_f32 v239, v239, v243, v247
v_lshlrev_b32 v240, 16, v72
v_lshlrev_b32 v244, 16, v76
v_lshlrev_b32 v241, 16, v73
v_lshlrev_b32 v245, 16, v77
v_lshlrev_b32 v242, 16, v74
v_lshlrev_b32 v246, 16, v78
v_lshlrev_b32 v243, 16, v75
v_lshlrev_b32 v247, 16, v79
v_maximum3_f32 v232, v232, v240, v244
v_maximum3_f32 v233, v233, v241, v245
v_maximum3_f32 v234, v234, v242, v246
v_maximum3_f32 v235, v235, v243, v247
v_and_b32 v240, s19, v72
v_and_b32 v244, s19, v76
v_and_b32 v241, s19, v73
v_and_b32 v245, s19, v77
v_and_b32 v242, s19, v74
v_and_b32 v246, s19, v78
v_and_b32 v243, s19, v75
v_and_b32 v247, s19, v79
v_maximum3_f32 v236, v236, v240, v244
v_maximum3_f32 v237, v237, v241, v245
v_maximum3_f32 v238, v238, v242, v246
v_maximum3_f32 v239, v239, v243, v247
v_lshlrev_b32 v240, 16, v80
v_lshlrev_b32 v244, 16, v84
v_lshlrev_b32 v241, 16, v81
v_lshlrev_b32 v245, 16, v85
v_lshlrev_b32 v242, 16, v82
v_lshlrev_b32 v246, 16, v86
v_lshlrev_b32 v243, 16, v83
v_lshlrev_b32 v247, 16, v87
v_maximum3_f32 v232, v232, v240, v244
v_maximum3_f32 v233, v233, v241, v245
v_maximum3_f32 v234, v234, v242, v246
v_maximum3_f32 v235, v235, v243, v247
v_and_b32 v240, s19, v80
v_and_b32 v244, s19, v84
v_and_b32 v241, s19, v81
v_and_b32 v245, s19, v85
v_and_b32 v242, s19, v82
v_and_b32 v246, s19, v86
v_and_b32 v243, s19, v83
v_and_b32 v247, s19, v87
v_maximum3_f32 v236, v236, v240, v244
v_maximum3_f32 v237, v237, v241, v245
v_maximum3_f32 v238, v238, v242, v246
v_maximum3_f32 v239, v239, v243, v247
v_lshlrev_b32 v240, 16, v88
v_lshlrev_b32 v244, 16, v92
v_lshlrev_b32 v241, 16, v89
v_lshlrev_b32 v245, 16, v93
v_lshlrev_b32 v242, 16, v90
v_lshlrev_b32 v246, 16, v94
v_lshlrev_b32 v243, 16, v91
v_lshlrev_b32 v247, 16, v95
v_maximum3_f32 v232, v232, v240, v244
v_maximum3_f32 v233, v233, v241, v245
v_maximum3_f32 v234, v234, v242, v246
v_maximum3_f32 v235, v235, v243, v247
v_and_b32 v240, s19, v88
v_and_b32 v244, s19, v92
v_and_b32 v241, s19, v89
v_and_b32 v245, s19, v93
v_and_b32 v242, s19, v90
v_and_b32 v246, s19, v94
v_and_b32 v243, s19, v91
v_and_b32 v247, s19, v95
v_maximum3_f32 v236, v236, v240, v244
v_maximum3_f32 v237, v237, v241, v245
v_maximum3_f32 v238, v238, v242, v246
v_maximum3_f32 v239, v239, v243, v247
v_lshlrev_b32 v240, 16, v96
v_lshlrev_b32 v244, 16, v100
v_lshlrev_b32 v241, 16, v97
v_lshlrev_b32 v245, 16, v101
v_lshlrev_b32 v242, 16, v98
v_lshlrev_b32 v246, 16, v102
v_lshlrev_b32 v243, 16, v99
v_lshlrev_b32 v247, 16, v103
v_maximum3_f32 v232, v232, v240, v244
v_maximum3_f32 v233, v233, v241, v245
v_maximum3_f32 v234, v234, v242, v246
v_maximum3_f32 v235, v235, v243, v247
v_and_b32 v240, s19, v96
v_and_b32 v244, s19, v100
v_and_b32 v241, s19, v97
v_and_b32 v245, s19, v101
v_and_b32 v242, s19, v98
v_and_b32 v246, s19, v102
v_and_b32 v243, s19, v99
v_and_b32 v247, s19, v103
v_maximum3_f32 v236, v236, v240, v244
v_maximum3_f32 v237, v237, v241, v245
v_maximum3_f32 v238, v238, v242, v246
v_maximum3_f32 v239, v239, v243, v247
v_lshlrev_b32 v240, 16, v104
v_lshlrev_b32 v244, 16, v108
v_lshlrev_b32 v241, 16, v105
v_lshlrev_b32 v245, 16, v109
v_lshlrev_b32 v242, 16, v106
v_lshlrev_b32 v246, 16, v110
v_lshlrev_b32 v243, 16, v107
v_lshlrev_b32 v247, 16, v111
v_maximum3_f32 v232, v232, v240, v244
v_maximum3_f32 v233, v233, v241, v245
v_maximum3_f32 v234, v234, v242, v246
v_maximum3_f32 v235, v235, v243, v247
v_and_b32 v240, s19, v104
v_and_b32 v244, s19, v108
v_and_b32 v241, s19, v105
v_and_b32 v245, s19, v109
v_and_b32 v242, s19, v106
v_and_b32 v246, s19, v110
v_and_b32 v243, s19, v107
v_and_b32 v247, s19, v111
v_maximum3_f32 v236, v236, v240, v244
v_maximum3_f32 v237, v237, v241, v245
v_maximum3_f32 v238, v238, v242, v246
v_maximum3_f32 v239, v239, v243, v247
v_lshlrev_b32 v240, 16, v112
v_lshlrev_b32 v244, 16, v116
v_lshlrev_b32 v241, 16, v113
v_lshlrev_b32 v245, 16, v117
v_lshlrev_b32 v242, 16, v114
v_lshlrev_b32 v246, 16, v118
v_lshlrev_b32 v243, 16, v115
v_lshlrev_b32 v247, 16, v119
v_maximum3_f32 v232, v232, v240, v244
v_maximum3_f32 v233, v233, v241, v245
v_maximum3_f32 v234, v234, v242, v246
v_maximum3_f32 v235, v235, v243, v247
v_and_b32 v240, s19, v112
v_and_b32 v244, s19, v116
v_and_b32 v241, s19, v113
v_and_b32 v245, s19, v117
v_and_b32 v242, s19, v114
v_and_b32 v246, s19, v118
v_and_b32 v243, s19, v115
v_and_b32 v247, s19, v119
v_maximum3_f32 v236, v236, v240, v244
v_maximum3_f32 v237, v237, v241, v245
v_maximum3_f32 v238, v238, v242, v246
v_maximum3_f32 v239, v239, v243, v247
v_lshlrev_b32 v240, 16, v120
v_lshlrev_b32 v244, 16, v124
v_lshlrev_b32 v241, 16, v121
v_lshlrev_b32 v245, 16, v125
v_lshlrev_b32 v242, 16, v122
v_lshlrev_b32 v246, 16, v126
v_lshlrev_b32 v243, 16, v123
v_lshlrev_b32 v247, 16, v127
v_maximum3_f32 v232, v232, v240, v244
v_maximum3_f32 v233, v233, v241, v245
v_maximum3_f32 v234, v234, v242, v246
v_maximum3_f32 v235, v235, v243, v247
v_and_b32 v240, s19, v120
v_and_b32 v244, s19, v124
v_and_b32 v241, s19, v121
v_and_b32 v245, s19, v125
v_and_b32 v242, s19, v122
v_and_b32 v246, s19, v126
v_and_b32 v243, s19, v123
v_and_b32 v247, s19, v127
v_maximum3_f32 v236, v236, v240, v244
v_maximum3_f32 v237, v237, v241, v245
v_maximum3_f32 v238, v238, v242, v246
v_maximum3_f32 v239, v239, v243, v247
s_nop 1
v_permlane32_swap_b32 v232, v234
v_permlane32_swap_b32 v233, v235
v_maximum3_f32 v232, v232, v234, v234
v_maximum3_f32 v233, v233, v235, v235
s_nop 1
v_permlane16_swap_b32 v232, v233
v_maximum3_f32 v232, v232, v233, v233
s_nop 1
v_mov_b32_dpp v233, v232 row_ror:8 row_mask:0xf bank_mask:0xf
v_maximum3_f32 v232, v232, v233, v233
s_nop 1
v_permlane32_swap_b32 v236, v238
v_permlane32_swap_b32 v237, v239
v_maximum3_f32 v236, v236, v238, v238
v_maximum3_f32 v237, v237, v239, v239
s_nop 1
v_permlane16_swap_b32 v236, v237
v_maximum3_f32 v236, v236, v237, v237
s_nop 1
v_mov_b32_dpp v237, v236 row_ror:8 row_mask:0xf bank_mask:0xf
v_maximum3_f32 v236, v236, v237, v237
v_perm_b32 v254, v236, v232, s22
s_branch L_exactdone
s_endpgm
L_pad:
.section .rodata,"a"
.p2align 6
.amdhsa_kernel standalone__channel_attn_cbam__vision_kernel
  .amdhsa_next_free_vgpr 256
  .amdhsa_next_free_sgpr 96
  .amdhsa_accum_offset 256
  .amdhsa_group_segment_fixed_size 0
  .amdhsa_kernarg_size 48
  .amdhsa_user_sgpr_count 2
  .amdhsa_user_sgpr_kernarg_segment_ptr 1
  .amdhsa_system_sgpr_workgroup_id_x 1
  .amdhsa_float_denorm_mode_32 3
.end_amdhsa_kernel
```
